```python
import torch

def _softmax(x, axis=-1):
    return torch.softmax(x, dim=axis)
def _gelu(x):
    return torch.nn.functional.gelu(x, approximate="tanh")
def _silu(x):
    return torch.nn.functional.silu(x)
def _sigmoid(x):
    return torch.sigmoid(x)
def _layernorm(x, axis=-1, eps=1e-5):
    m = x.mean(dim=axis, keepdim=True)
    v = x.var(dim=axis, keepdim=True, unbiased=False)
    return (x - m) / torch.sqrt(v + eps)
def _scatter_add(tgt, idx, src, axis=0):
    return tgt.clone().index_add_(axis, idx, src)
def _segment_sum(src, seg, n):
    out = torch.zeros((n,) + src.shape[1:], dtype=src.dtype)
    return out.index_add_(0, seg, src)
def _pad(x, pw):
    flat = tuple(v for pair in reversed(pw) for v in pair)
    return torch.nn.functional.pad(x, flat)

kernel_name = 'standalone__instancenorm__prompt'

def setup_inputs():

    _w = (lambda a: (lambda t: t.to(torch.bfloat16) if t.is_floating_point() else t)(torch.as_tensor(a)))
    B, C, H, W = 1, 512, 2048, 32
    return {
        "x": _w(abs((lambda *s: torch.randn(*s, dtype=torch.bfloat16) * 0.05)(B, C, H, W))),
        "g": _w((lambda *s: torch.randn(*s, dtype=torch.bfloat16) * 0.05)(C) + 1.0),
        "b": _w((lambda *s: torch.randn(*s, dtype=torch.bfloat16) * 0.4)(C)),
    }

def reference(x, g, b):
    mu = x.mean(axis=(-2, -1), keepdims=True)
    var = ((x - mu) ** 2).mean(axis=(-2, -1), keepdims=True)
    xhat = (x - mu) / torch.sqrt(var + 1e-5)
    return xhat * g.reshape(1, -1, 1, 1) + b.reshape(1, -1, 1, 1)
```

```asm
; @launch grid=(256,1,1) block=(1024,1,1) lds=16
.amdgcn_target "amdgcn-amd-amdhsa--gfx950"
.text
.globl standalone__instancenorm__prompt_kernel
.p2align 8
.type standalone__instancenorm__prompt_kernel,@function
standalone__instancenorm__prompt_kernel:
    s_load_dwordx8 s[4:11], s[0:1], 0
    s_load_dwordx4 s[12:15], s[0:1], 32
    v_readfirstlane_b32 s25, v0
    v_and_b32 v0, 63, v0
    v_lshlrev_b32 v0, 4, v0
    s_mov_b64 s[26:27], 0
    s_andn2_b32 s3, s2, 8
    s_or_b32 s3, s3, s25
    s_cbranch_scc1 L_second
    s_setprio 3
    v_lshrrev_b32 v2, 9, v0
    v_mul_u32_u24 v2, 0x10200, v2
    v_add_u32 v2, v2, v0
    v_lshrrev_b32 v2, 2, v2
    s_mul_i32 s3, s2, 0x8400
    v_add_u32 v2, s3, v2
    v_xor_b32 v10, 0x2000, v2
    s_waitcnt lgkmcnt(0)
    s_xor_b32 s3, s4, s10
    s_bitcmp1_b32 s3, 12
    s_cbranch_scc0 L_aligned
    global_store_dword v2, v0, s[10:11] offset:2048 sc1
    global_store_dword v10, v0, s[10:11] offset:2048 sc1
    s_waitcnt vmcnt(1)
    s_nop 8
    s_getreg_b32 s3, hwreg(HW_REG_IB_STS, 0, 1)
L_say:
    s_getreg_b32 s44, hwreg(HW_REG_XCC_ID, 0, 2)
    s_lshl2_add_u32 s3, s3, s44
    s_lshr_b32 s44, s2, 1
    s_xor_b32 s3, s3, s44
    s_xor_b32 s3, s3, 12
    s_mov_b32 s26, s3
    s_atomic_cmpswap s[26:27], s[12:13], 0 glc
    s_waitcnt lgkmcnt(0)
    s_cmp_eq_u32 s26, 0
    s_cselect_b32 s26, s3, s26
    s_atomic_or s26, s[12:13], 128
L_second:
    v_mov_b32 v6, 0
    v_mov_b32 v7, 0
    v_mov_b32 v8, 0
    v_mov_b32 v9, 0
    s_sub_u32 s3, s2, 1
    s_andn2_b32 s44, s3, 0x1c
    s_xor_b32 s45, s25, 64
    s_or_b32 s44, s44, s45
    s_cbranch_scc1 L_setup
    s_lshl_b32 s44, s3, 10
    v_add_u32 v11, s44, v0
    s_lshr_b32 s3, s3, 2
    s_lshl_b32 s63, 1, s3
    s_waitcnt lgkmcnt(0)
    global_store_dwordx4 v11, v[6:9], s[14:15] offset:0 sc1
    global_store_dwordx4 v11, v[6:9], s[14:15] offset:1024 sc1
    global_store_dwordx4 v11, v[6:9], s[14:15] offset:2048 sc1
    global_store_dwordx4 v11, v[6:9], s[14:15] offset:3072 sc1
    s_waitcnt vmcnt(0)
    s_atomic_or s63, s[12:13], 192
L_setup:
    s_cmpk_ge_u32 s2, 256
    s_cbranch_scc1 L_end
    s_setprio 2
    v_mov_b32 v14, 0
    s_lshr_b32 s25, s25, 6
    s_lshr_b32 s43, s2, 3
    s_and_b32 s37, s2, 7
    s_mul_i32 s3, s25, s37
    s_add_u32 s3, s43, s3
    s_and_b32 s3, s3, 3
    s_andn2_b32 s43, s43, 3
    s_or_b32 s43, s43, s3
    s_and_b32 s36, s25, 7
    s_lshl_b32 s36, s36, 5
    s_add_u32 s36, s36, s43
    s_lshr_b32 s3, s25, 3
    s_lshl1_add_u32 s36, s36, s3
    s_lshl_b32 s62, s36, 17
    s_mov_b32 s18, 0x20000
    s_mov_b32 s19, 0x20000
    s_lshl_b32 s38, s37, 14
    s_add_u32 s39, s38, 0x1000
    s_add_u32 s40, s38, 0x2000
    s_add_u32 s41, s38, 0x3000
    s_mov_b32 s35, 0x400000
    s_mov_b32 s61, s37
    s_bitcmp1_b32 0xe, s25
    s_cselect_b32 s42, 1, 0
    s_cbranch_scc1 L_go
    s_waitcnt lgkmcnt(0)
    s_add_u32 s44, s10, 0x800
    s_add_u32 s3, s10, s62
    s_xor_b32 s3, s3, s44
    s_lshl_b32 s44, s44, 8
    s_xor_b32 s3, s3, s44
    s_bfe_u32 s3, s3, 0x10015
    s_lshl2_add_u32 s46, s3, s37
    s_and_b32 s45, s37, 3
    s_lshl_b32 s3, s45, 15
    s_and_b32 s44, s10, 0x3000
    s_sub_u32 s44, s3, s44
    s_mov_b32 s48, 0x1
    s_mov_b32 s49, 0xc6708ab4
    s_lshl_b32 s3, s25, 2
    s_lshr_b64 s[48:49], s[48:49], s3
    s_and_b32 s48, s48, 15
    s_cmp_lg_u32 s25, 0
    s_cbranch_scc1 L_wait
    s_cmp_lg_u32 s26, 0
    s_cbranch_scc1 L_heard
    s_sleep 28
    s_load_dword s26, s[12:13], 0
    s_waitcnt lgkmcnt(0)
    s_cmp_lg_u32 s26, 0
    s_cbranch_scc1 L_heard
    s_sleep 2
    s_load_dword s26, s[12:13], 128
    s_waitcnt lgkmcnt(0)
    s_cmp_lg_u32 s26, 0
    s_cbranch_scc0 L_look
L_heard:
    v_mov_b32 v10, s26
    ds_write_b32 v14, v10
    ds_write_b64 v14, v[6:7] offset:8
    s_waitcnt lgkmcnt(0)
L_wait:
    s_barrier
    ds_read_b32 v10, v14
    s_waitcnt lgkmcnt(0)
    v_readfirstlane_b32 s3, v10
    s_bitcmp1_b32 s3, 4
    s_cbranch_scc1 L_split
    s_add_u32 s3, s3, s46
    s_and_b32 s3, s3, 4
    s_add_u32 s61, s3, s45
    s_lshl_b32 s3, s3, 11
    s_add_u32 s3, s3, s44
    s_and_b32 s38, s3, 0x1f000
    s_add_u32 s40, s3, 0x4000
    s_add_u32 s41, s3, 0x5000
    s_addk_i32 s3, 0x1000
    s_and_b32 s39, s3, 0x1f000
L_split:
    s_cmp_eq_u32 s48, 0
    s_cbranch_scc1 L_go
L_turn:
    s_sleep 2
    ds_read_b32 v10, v14 offset:8
    s_sub_u32 s35, s35, 1
    s_cbranch_scc1 L_end
    s_waitcnt lgkmcnt(0)
    v_readfirstlane_b32 s3, v10
    s_cmp_lt_u32 s3, s48
    s_cbranch_scc1 L_turn
L_go:
    s_andn2_b32 s3, s2, 8
    s_cbranch_scc0 L_yield
L_go2:
    s_waitcnt lgkmcnt(0)
    s_add_u32 s16, s4, s62
    s_addc_u32 s17, s5, 0
    buffer_load_dwordx4 v[16:19], v0, s[16:19], s38 offen nt
    buffer_load_dwordx4 v[20:23], v0, s[16:19], s39 offen nt
    buffer_load_dwordx4 v[24:27], v0, s[16:19], s38 offen offset:1024 nt
    buffer_load_dwordx4 v[28:31], v0, s[16:19], s39 offen offset:1024 nt
    buffer_load_dwordx4 v[32:35], v0, s[16:19], s38 offen offset:2048 nt
    buffer_load_dwordx4 v[36:39], v0, s[16:19], s39 offen offset:2048 nt
    buffer_load_dwordx4 v[40:43], v0, s[16:19], s38 offen offset:3072 nt
    buffer_load_dwordx4 v[44:47], v0, s[16:19], s39 offen offset:3072 nt
    buffer_load_dwordx4 v[48:51], v0, s[16:19], s40 offen nt
    buffer_load_dwordx4 v[52:55], v0, s[16:19], s41 offen nt
    buffer_load_dwordx4 v[56:59], v0, s[16:19], s40 offen offset:1024 nt
    buffer_load_dwordx4 v[60:63], v0, s[16:19], s41 offen offset:1024 nt
    buffer_load_dwordx4 v[64:67], v0, s[16:19], s40 offen offset:2048 nt
    buffer_load_dwordx4 v[68:71], v0, s[16:19], s41 offen offset:2048 nt
    buffer_load_dwordx4 v[72:75], v0, s[16:19], s40 offen offset:3072 nt
    buffer_load_dwordx4 v[76:79], v0, s[16:19], s41 offen offset:3072 nt
    s_cmp_eq_u32 s42, 0
    s_cbranch_scc1 L_loaded
    s_barrier
L_loaded:
    s_cmp_eq_u32 s25, 3
    s_cbranch_scc1 L_getbits
L_gotbits:
    s_load_dword s30, s[16:17], 0
    s_lshr_b32 s3, s36, 1
    s_lshl_b32 s3, s3, 2
    s_load_dword s31, s[6:7], s3
    s_load_dword s32, s[8:9], s3
    s_add_u32 s20, s10, s62
    s_addc_u32 s21, s11, 0
    s_mov_b64 s[22:23], s[18:19]
    s_lshl4_add_u32 s3, s43, s25
    s_lshl_b32 s3, s3, 6
    s_add_u32 s28, s14, s3
    s_addc_u32 s29, s15, 0
    s_lshl_b32 s61, s61, 3
    v_mov_b32 v1, 0x3f803f80
    s_mov_b32 s24, 0xffff0000
    v_and_b32 v96, 48, v0
    v_mov_b32 v100, 0x3f80
    v_mov_b32 v101, 0
    v_lshlrev_b64 v[100:101], v96, v[100:101]
    s_waitcnt vmcnt(15)
    v_dot2c_f32_bf16 v6, v16, v1
    v_dot2c_f32_bf16 v7, v16, v16
    v_dot2c_f32_bf16 v8, v17, v1
    v_dot2c_f32_bf16 v9, v17, v17
    v_dot2c_f32_bf16 v6, v18, v1
    v_dot2c_f32_bf16 v7, v18, v18
    v_dot2c_f32_bf16 v8, v19, v1
    v_dot2c_f32_bf16 v9, v19, v19
    s_waitcnt vmcnt(14)
    v_dot2c_f32_bf16 v6, v20, v1
    v_dot2c_f32_bf16 v7, v20, v20
    v_dot2c_f32_bf16 v8, v21, v1
    v_dot2c_f32_bf16 v9, v21, v21
    v_dot2c_f32_bf16 v6, v22, v1
    v_dot2c_f32_bf16 v7, v22, v22
    v_dot2c_f32_bf16 v8, v23, v1
    v_dot2c_f32_bf16 v9, v23, v23
    s_waitcnt vmcnt(13)
    v_dot2c_f32_bf16 v6, v24, v1
    v_dot2c_f32_bf16 v7, v24, v24
    v_dot2c_f32_bf16 v8, v25, v1
    v_dot2c_f32_bf16 v9, v25, v25
    v_dot2c_f32_bf16 v6, v26, v1
    v_dot2c_f32_bf16 v7, v26, v26
    v_dot2c_f32_bf16 v8, v27, v1
    v_dot2c_f32_bf16 v9, v27, v27
    s_waitcnt vmcnt(12)
    v_dot2c_f32_bf16 v6, v28, v1
    v_dot2c_f32_bf16 v7, v28, v28
    v_dot2c_f32_bf16 v8, v29, v1
    v_dot2c_f32_bf16 v9, v29, v29
    v_dot2c_f32_bf16 v6, v30, v1
    v_dot2c_f32_bf16 v7, v30, v30
    v_dot2c_f32_bf16 v8, v31, v1
    v_dot2c_f32_bf16 v9, v31, v31
    s_waitcnt vmcnt(11)
    v_dot2c_f32_bf16 v6, v32, v1
    v_dot2c_f32_bf16 v7, v32, v32
    v_dot2c_f32_bf16 v8, v33, v1
    v_dot2c_f32_bf16 v9, v33, v33
    v_dot2c_f32_bf16 v6, v34, v1
    v_dot2c_f32_bf16 v7, v34, v34
    v_dot2c_f32_bf16 v8, v35, v1
    v_dot2c_f32_bf16 v9, v35, v35
    s_waitcnt vmcnt(10)
    v_dot2c_f32_bf16 v6, v36, v1
    v_dot2c_f32_bf16 v7, v36, v36
    v_dot2c_f32_bf16 v8, v37, v1
    v_dot2c_f32_bf16 v9, v37, v37
    v_dot2c_f32_bf16 v6, v38, v1
    v_dot2c_f32_bf16 v7, v38, v38
    v_dot2c_f32_bf16 v8, v39, v1
    v_dot2c_f32_bf16 v9, v39, v39
    s_waitcnt vmcnt(9)
    v_dot2c_f32_bf16 v6, v40, v1
    v_dot2c_f32_bf16 v7, v40, v40
    v_dot2c_f32_bf16 v8, v41, v1
    v_dot2c_f32_bf16 v9, v41, v41
    v_dot2c_f32_bf16 v6, v42, v1
    v_dot2c_f32_bf16 v7, v42, v42
    v_dot2c_f32_bf16 v8, v43, v1
    v_dot2c_f32_bf16 v9, v43, v43
    s_waitcnt vmcnt(8)
    v_dot2c_f32_bf16 v6, v44, v1
    v_dot2c_f32_bf16 v7, v44, v44
    v_dot2c_f32_bf16 v8, v45, v1
    v_dot2c_f32_bf16 v9, v45, v45
    v_dot2c_f32_bf16 v6, v46, v1
    v_dot2c_f32_bf16 v7, v46, v46
    v_dot2c_f32_bf16 v8, v47, v1
    v_dot2c_f32_bf16 v9, v47, v47
    s_waitcnt vmcnt(7)
    v_dot2c_f32_bf16 v6, v48, v1
    v_dot2c_f32_bf16 v7, v48, v48
    v_dot2c_f32_bf16 v8, v49, v1
    v_dot2c_f32_bf16 v9, v49, v49
    v_dot2c_f32_bf16 v6, v50, v1
    v_dot2c_f32_bf16 v7, v50, v50
    v_dot2c_f32_bf16 v8, v51, v1
    v_dot2c_f32_bf16 v9, v51, v51
    s_waitcnt vmcnt(6)
    v_dot2c_f32_bf16 v6, v52, v1
    v_dot2c_f32_bf16 v7, v52, v52
    v_dot2c_f32_bf16 v8, v53, v1
    v_dot2c_f32_bf16 v9, v53, v53
    v_dot2c_f32_bf16 v6, v54, v1
    v_dot2c_f32_bf16 v7, v54, v54
    v_dot2c_f32_bf16 v8, v55, v1
    v_dot2c_f32_bf16 v9, v55, v55
    s_waitcnt vmcnt(5)
    v_dot2c_f32_bf16 v6, v56, v1
    v_dot2c_f32_bf16 v7, v56, v56
    v_dot2c_f32_bf16 v8, v57, v1
    v_dot2c_f32_bf16 v9, v57, v57
    v_dot2c_f32_bf16 v6, v58, v1
    v_dot2c_f32_bf16 v7, v58, v58
    v_dot2c_f32_bf16 v8, v59, v1
    v_dot2c_f32_bf16 v9, v59, v59
    s_waitcnt vmcnt(4)
    v_dot2c_f32_bf16 v6, v60, v1
    v_dot2c_f32_bf16 v7, v60, v60
    v_dot2c_f32_bf16 v8, v61, v1
    v_dot2c_f32_bf16 v9, v61, v61
    v_dot2c_f32_bf16 v6, v62, v1
    v_dot2c_f32_bf16 v7, v62, v62
    v_dot2c_f32_bf16 v8, v63, v1
    v_dot2c_f32_bf16 v9, v63, v63
    s_waitcnt vmcnt(3)
    v_dot2c_f32_bf16 v6, v64, v1
    v_dot2c_f32_bf16 v7, v64, v64
    v_dot2c_f32_bf16 v8, v65, v1
    v_dot2c_f32_bf16 v9, v65, v65
    v_dot2c_f32_bf16 v6, v66, v1
    v_dot2c_f32_bf16 v7, v66, v66
    v_dot2c_f32_bf16 v8, v67, v1
    v_dot2c_f32_bf16 v9, v67, v67
    s_waitcnt vmcnt(2)
    v_dot2c_f32_bf16 v6, v68, v1
    v_dot2c_f32_bf16 v7, v68, v68
    v_dot2c_f32_bf16 v8, v69, v1
    v_dot2c_f32_bf16 v9, v69, v69
    v_dot2c_f32_bf16 v6, v70, v1
    v_dot2c_f32_bf16 v7, v70, v70
    v_dot2c_f32_bf16 v8, v71, v1
    v_dot2c_f32_bf16 v9, v71, v71
    s_waitcnt vmcnt(1)
    v_dot2c_f32_bf16 v6, v72, v1
    v_dot2c_f32_bf16 v7, v72, v72
    v_dot2c_f32_bf16 v8, v73, v1
    v_dot2c_f32_bf16 v9, v73, v73
    v_dot2c_f32_bf16 v6, v74, v1
    v_dot2c_f32_bf16 v7, v74, v74
    v_dot2c_f32_bf16 v8, v75, v1
    v_dot2c_f32_bf16 v9, v75, v75
    s_waitcnt vmcnt(0)
    v_dot2c_f32_bf16 v6, v76, v1
    v_dot2c_f32_bf16 v7, v76, v76
    v_dot2c_f32_bf16 v8, v77, v1
    v_dot2c_f32_bf16 v9, v77, v77
    v_dot2c_f32_bf16 v6, v78, v1
    v_dot2c_f32_bf16 v7, v78, v78
    v_dot2c_f32_bf16 v8, v79, v1
    v_dot2c_f32_bf16 v9, v79, v79
    ds_read_b32 v3, v14 offset:12
    s_setprio 3
    s_waitcnt lgkmcnt(0)
    s_lshl_b32 s30, s30, 16
    s_xor_b32 s30, s30, 0x80000000
    v_mov_b32 v2, 0x42800000
    v_fmac_f32 v7, s30, v6
    v_fmac_f32 v9, s30, v8
    v_fmac_f32 v6, s30, v2
    v_fmac_f32 v8, s30, v2
    v_fmac_f32 v7, s30, v6
    v_fmac_f32 v9, s30, v8
    v_pk_add_f32 v[6:7], v[6:7], v[8:9]
    s_nop 1
    v_add_f32_dpp v6, v6, v6 row_ror:8 row_mask:0xf bank_mask:0xf
    v_add_f32_dpp v7, v7, v7 row_ror:8 row_mask:0xf bank_mask:0xf
    s_nop 0
    v_add_f32_dpp v6, v6, v6 row_ror:4 row_mask:0xf bank_mask:0xf
    v_add_f32_dpp v7, v7, v7 row_ror:4 row_mask:0xf bank_mask:0xf
    s_nop 0
    v_add_f32_dpp v6, v6, v6 row_ror:2 row_mask:0xf bank_mask:0xf
    v_add_f32_dpp v7, v7, v7 row_ror:2 row_mask:0xf bank_mask:0xf
    s_nop 0
    v_add_f32_dpp v6, v6, v6 row_ror:1 row_mask:0xf bank_mask:0xf
    v_add_f32_dpp v7, v7, v7 row_ror:1 row_mask:0xf bank_mask:0xf
    s_nop 0
    v_add_f32_dpp v6, v6, v6 row_bcast:15 row_mask:0xa bank_mask:0xf
    v_add_f32_dpp v7, v7, v7 row_bcast:15 row_mask:0xa bank_mask:0xf
    s_nop 0
    v_add_f32_dpp v6, v6, v6 row_bcast:31 row_mask:0xc bank_mask:0xf
    v_add_f32_dpp v7, v7, v7 row_bcast:31 row_mask:0xc bank_mask:0xf
    v_readfirstlane_b32 s3, v3
    v_readlane_b32 s4, v6, 63
    v_readlane_b32 s5, v7, 63
    s_cmp_eq_u32 s3, 0
    s_cbranch_scc1 L_notempty
L_empty:
    s_or_b32 s4, s4, 1
    s_and_b32 s3, s36, 1
    s_atomic_add_x2 s[4:5], s[28:29], s61
    s_lshl_b32 s3, s3, 4
    s_lshr_b32 s31, s31, s3
    s_lshl_b32 s31, s31, 16
    s_lshr_b32 s32, s32, s3
    s_lshl_b32 s32, s32, 16
    v_mov_b32 v3, 1
L_poll:
    s_sleep 2
    s_load_dwordx16 s[44:59], s[28:29], 0 glc
    s_sub_u32 s35, s35, 1
    s_cbranch_scc1 L_end
    s_waitcnt lgkmcnt(0)
    s_and_b32 s3, s44, s46
    s_and_b32 s3, s3, s48
    s_and_b32 s3, s3, s50
    s_and_b32 s3, s3, s52
    s_and_b32 s3, s3, s54
    s_and_b32 s3, s3, s56
    s_and_b32 s3, s3, s58
    s_bitcmp1_b32 s3, 0
    s_cbranch_scc0 L_poll
    s_mov_b64 exec, 1
    ds_add_u32 v14, v3 offset:8
    s_mov_b64 exec, -1
    s_setprio 1
    s_cmp_eq_u32 s42, 0
    s_cbranch_scc1 L_prio
    s_setprio 0
L_prio:
    v_mov_b32 v6, s44
    v_mov_b32 v7, s45
    v_pk_add_f32 v[6:7], v[6:7], s[46:47]
    v_pk_add_f32 v[6:7], v[6:7], s[48:49]
    v_pk_add_f32 v[6:7], v[6:7], s[50:51]
    v_pk_add_f32 v[6:7], v[6:7], s[52:53]
    v_pk_add_f32 v[6:7], v[6:7], s[54:55]
    v_pk_add_f32 v[6:7], v[6:7], s[56:57]
    v_pk_add_f32 v[6:7], v[6:7], s[58:59]
    v_mul_f32 v6, 0x37800000, v6
    v_mul_f32 v7, 0x37800000, v7
    v_subrev_f32 v8, s30, v6
    v_fma_f32 v7, -v6, v6, v7
    v_cvt_pk_bf16_f32 v8, v8, v8
    v_max_f32 v7, 0, v7
    v_and_b32 v8, s24, v8
    v_add_f32 v9, s30, v8
    v_sub_f32 v96, 0, v8
    v_sub_f32 v97, 0, v8
    v_sub_f32 v98, 0, v8
    v_sub_f32 v99, 0, v8
    v_sub_f32 v9, v9, v6
    v_fma_f32 v7, v9, v9, v7
    v_cvt_pk_bf16_f32 v7, v7, v7
    v_and_b32 v7, s24, v7
    v_add_f32 v7, 0x3727c5ac, v7
    v_cvt_pk_bf16_f32 v7, v7, v7
    v_and_b32 v7, s24, v7
    v_sqrt_f32 v7, v7
    v_mov_b32 v5, s32
    v_cvt_pk_bf16_f32 v7, v7, v7
    v_and_b32 v7, s24, v7
    v_rcp_f32 v7, v7
    s_nop 0
    v_mul_f32 v4, s31, v7
    v_mfma_f32_4x4x4_16b_bf16 v[80:83], v[100:101], v[16:17], v[96:99]
    v_mfma_f32_4x4x4_16b_bf16 v[84:87], v[100:101], v[18:19], v[96:99]
    v_mfma_f32_4x4x4_16b_bf16 v[88:91], v[100:101], v[20:21], v[96:99]
    v_mfma_f32_4x4x4_16b_bf16 v[92:95], v[100:101], v[22:23], v[96:99]
    s_nop 2
    v_pk_fma_f32 v[80:81], v[80:81], v[4:5], v[4:5] op_sel:[0,0,1] op_sel_hi:[1,0,1]
    v_pk_fma_f32 v[82:83], v[82:83], v[4:5], v[4:5] op_sel:[0,0,1] op_sel_hi:[1,0,1]
    v_pk_fma_f32 v[84:85], v[84:85], v[4:5], v[4:5] op_sel:[0,0,1] op_sel_hi:[1,0,1]
    v_pk_fma_f32 v[86:87], v[86:87], v[4:5], v[4:5] op_sel:[0,0,1] op_sel_hi:[1,0,1]
    v_cvt_pk_bf16_f32 v16, v80, v81
    v_cvt_pk_bf16_f32 v17, v82, v83
    v_cvt_pk_bf16_f32 v18, v84, v85
    v_cvt_pk_bf16_f32 v19, v86, v87
    v_mfma_f32_4x4x4_16b_bf16 v[80:83], v[100:101], v[24:25], v[96:99]
    v_mfma_f32_4x4x4_16b_bf16 v[84:87], v[100:101], v[26:27], v[96:99]
    v_pk_fma_f32 v[88:89], v[88:89], v[4:5], v[4:5] op_sel:[0,0,1] op_sel_hi:[1,0,1]
    v_pk_fma_f32 v[90:91], v[90:91], v[4:5], v[4:5] op_sel:[0,0,1] op_sel_hi:[1,0,1]
    v_pk_fma_f32 v[92:93], v[92:93], v[4:5], v[4:5] op_sel:[0,0,1] op_sel_hi:[1,0,1]
    v_pk_fma_f32 v[94:95], v[94:95], v[4:5], v[4:5] op_sel:[0,0,1] op_sel_hi:[1,0,1]
    v_cvt_pk_bf16_f32 v20, v88, v89
    v_cvt_pk_bf16_f32 v21, v90, v91
    v_cvt_pk_bf16_f32 v22, v92, v93
    v_cvt_pk_bf16_f32 v23, v94, v95
    v_mfma_f32_4x4x4_16b_bf16 v[88:91], v[100:101], v[28:29], v[96:99]
    v_mfma_f32_4x4x4_16b_bf16 v[92:95], v[100:101], v[30:31], v[96:99]
    v_pk_fma_f32 v[80:81], v[80:81], v[4:5], v[4:5] op_sel:[0,0,1] op_sel_hi:[1,0,1]
    v_pk_fma_f32 v[82:83], v[82:83], v[4:5], v[4:5] op_sel:[0,0,1] op_sel_hi:[1,0,1]
    v_pk_fma_f32 v[84:85], v[84:85], v[4:5], v[4:5] op_sel:[0,0,1] op_sel_hi:[1,0,1]
    v_pk_fma_f32 v[86:87], v[86:87], v[4:5], v[4:5] op_sel:[0,0,1] op_sel_hi:[1,0,1]
    v_cvt_pk_bf16_f32 v24, v80, v81
    v_cvt_pk_bf16_f32 v25, v82, v83
    v_cvt_pk_bf16_f32 v26, v84, v85
    v_cvt_pk_bf16_f32 v27, v86, v87
    v_mfma_f32_4x4x4_16b_bf16 v[80:83], v[100:101], v[32:33], v[96:99]
    v_mfma_f32_4x4x4_16b_bf16 v[84:87], v[100:101], v[34:35], v[96:99]
    v_pk_fma_f32 v[88:89], v[88:89], v[4:5], v[4:5] op_sel:[0,0,1] op_sel_hi:[1,0,1]
    v_pk_fma_f32 v[90:91], v[90:91], v[4:5], v[4:5] op_sel:[0,0,1] op_sel_hi:[1,0,1]
    v_pk_fma_f32 v[92:93], v[92:93], v[4:5], v[4:5] op_sel:[0,0,1] op_sel_hi:[1,0,1]
    v_pk_fma_f32 v[94:95], v[94:95], v[4:5], v[4:5] op_sel:[0,0,1] op_sel_hi:[1,0,1]
    v_cvt_pk_bf16_f32 v28, v88, v89
    v_cvt_pk_bf16_f32 v29, v90, v91
    v_cvt_pk_bf16_f32 v30, v92, v93
    v_cvt_pk_bf16_f32 v31, v94, v95
    v_mfma_f32_4x4x4_16b_bf16 v[88:91], v[100:101], v[36:37], v[96:99]
    v_mfma_f32_4x4x4_16b_bf16 v[92:95], v[100:101], v[38:39], v[96:99]
    v_pk_fma_f32 v[80:81], v[80:81], v[4:5], v[4:5] op_sel:[0,0,1] op_sel_hi:[1,0,1]
    v_pk_fma_f32 v[82:83], v[82:83], v[4:5], v[4:5] op_sel:[0,0,1] op_sel_hi:[1,0,1]
    v_pk_fma_f32 v[84:85], v[84:85], v[4:5], v[4:5] op_sel:[0,0,1] op_sel_hi:[1,0,1]
    v_pk_fma_f32 v[86:87], v[86:87], v[4:5], v[4:5] op_sel:[0,0,1] op_sel_hi:[1,0,1]
    v_cvt_pk_bf16_f32 v32, v80, v81
    v_cvt_pk_bf16_f32 v33, v82, v83
    v_cvt_pk_bf16_f32 v34, v84, v85
    v_cvt_pk_bf16_f32 v35, v86, v87
    v_mfma_f32_4x4x4_16b_bf16 v[80:83], v[100:101], v[40:41], v[96:99]
    v_mfma_f32_4x4x4_16b_bf16 v[84:87], v[100:101], v[42:43], v[96:99]
    v_pk_fma_f32 v[88:89], v[88:89], v[4:5], v[4:5] op_sel:[0,0,1] op_sel_hi:[1,0,1]
    v_pk_fma_f32 v[90:91], v[90:91], v[4:5], v[4:5] op_sel:[0,0,1] op_sel_hi:[1,0,1]
    v_pk_fma_f32 v[92:93], v[92:93], v[4:5], v[4:5] op_sel:[0,0,1] op_sel_hi:[1,0,1]
    v_pk_fma_f32 v[94:95], v[94:95], v[4:5], v[4:5] op_sel:[0,0,1] op_sel_hi:[1,0,1]
    v_cvt_pk_bf16_f32 v36, v88, v89
    v_cvt_pk_bf16_f32 v37, v90, v91
    v_cvt_pk_bf16_f32 v38, v92, v93
    v_cvt_pk_bf16_f32 v39, v94, v95
    v_mfma_f32_4x4x4_16b_bf16 v[88:91], v[100:101], v[44:45], v[96:99]
    v_mfma_f32_4x4x4_16b_bf16 v[92:95], v[100:101], v[46:47], v[96:99]
    v_pk_fma_f32 v[80:81], v[80:81], v[4:5], v[4:5] op_sel:[0,0,1] op_sel_hi:[1,0,1]
    v_pk_fma_f32 v[82:83], v[82:83], v[4:5], v[4:5] op_sel:[0,0,1] op_sel_hi:[1,0,1]
    v_pk_fma_f32 v[84:85], v[84:85], v[4:5], v[4:5] op_sel:[0,0,1] op_sel_hi:[1,0,1]
    v_pk_fma_f32 v[86:87], v[86:87], v[4:5], v[4:5] op_sel:[0,0,1] op_sel_hi:[1,0,1]
    v_cvt_pk_bf16_f32 v40, v80, v81
    v_cvt_pk_bf16_f32 v41, v82, v83
    v_cvt_pk_bf16_f32 v42, v84, v85
    v_cvt_pk_bf16_f32 v43, v86, v87
    v_mfma_f32_4x4x4_16b_bf16 v[80:83], v[100:101], v[48:49], v[96:99]
    v_mfma_f32_4x4x4_16b_bf16 v[84:87], v[100:101], v[50:51], v[96:99]
    v_pk_fma_f32 v[88:89], v[88:89], v[4:5], v[4:5] op_sel:[0,0,1] op_sel_hi:[1,0,1]
    v_pk_fma_f32 v[90:91], v[90:91], v[4:5], v[4:5] op_sel:[0,0,1] op_sel_hi:[1,0,1]
    v_pk_fma_f32 v[92:93], v[92:93], v[4:5], v[4:5] op_sel:[0,0,1] op_sel_hi:[1,0,1]
    v_pk_fma_f32 v[94:95], v[94:95], v[4:5], v[4:5] op_sel:[0,0,1] op_sel_hi:[1,0,1]
    v_cvt_pk_bf16_f32 v44, v88, v89
    v_cvt_pk_bf16_f32 v45, v90, v91
    v_cvt_pk_bf16_f32 v46, v92, v93
    v_cvt_pk_bf16_f32 v47, v94, v95
    v_mfma_f32_4x4x4_16b_bf16 v[88:91], v[100:101], v[52:53], v[96:99]
    v_mfma_f32_4x4x4_16b_bf16 v[92:95], v[100:101], v[54:55], v[96:99]
    v_pk_fma_f32 v[80:81], v[80:81], v[4:5], v[4:5] op_sel:[0,0,1] op_sel_hi:[1,0,1]
    v_pk_fma_f32 v[82:83], v[82:83], v[4:5], v[4:5] op_sel:[0,0,1] op_sel_hi:[1,0,1]
    v_pk_fma_f32 v[84:85], v[84:85], v[4:5], v[4:5] op_sel:[0,0,1] op_sel_hi:[1,0,1]
    v_pk_fma_f32 v[86:87], v[86:87], v[4:5], v[4:5] op_sel:[0,0,1] op_sel_hi:[1,0,1]
    v_cvt_pk_bf16_f32 v48, v80, v81
    v_cvt_pk_bf16_f32 v49, v82, v83
    v_cvt_pk_bf16_f32 v50, v84, v85
    v_cvt_pk_bf16_f32 v51, v86, v87
    v_mfma_f32_4x4x4_16b_bf16 v[80:83], v[100:101], v[56:57], v[96:99]
    v_mfma_f32_4x4x4_16b_bf16 v[84:87], v[100:101], v[58:59], v[96:99]
    v_pk_fma_f32 v[88:89], v[88:89], v[4:5], v[4:5] op_sel:[0,0,1] op_sel_hi:[1,0,1]
    v_pk_fma_f32 v[90:91], v[90:91], v[4:5], v[4:5] op_sel:[0,0,1] op_sel_hi:[1,0,1]
    v_pk_fma_f32 v[92:93], v[92:93], v[4:5], v[4:5] op_sel:[0,0,1] op_sel_hi:[1,0,1]
    v_pk_fma_f32 v[94:95], v[94:95], v[4:5], v[4:5] op_sel:[0,0,1] op_sel_hi:[1,0,1]
    v_cvt_pk_bf16_f32 v52, v88, v89
    v_cvt_pk_bf16_f32 v53, v90, v91
    v_cvt_pk_bf16_f32 v54, v92, v93
    v_cvt_pk_bf16_f32 v55, v94, v95
    v_mfma_f32_4x4x4_16b_bf16 v[88:91], v[100:101], v[60:61], v[96:99]
    v_mfma_f32_4x4x4_16b_bf16 v[92:95], v[100:101], v[62:63], v[96:99]
    v_pk_fma_f32 v[80:81], v[80:81], v[4:5], v[4:5] op_sel:[0,0,1] op_sel_hi:[1,0,1]
    v_pk_fma_f32 v[82:83], v[82:83], v[4:5], v[4:5] op_sel:[0,0,1] op_sel_hi:[1,0,1]
    v_pk_fma_f32 v[84:85], v[84:85], v[4:5], v[4:5] op_sel:[0,0,1] op_sel_hi:[1,0,1]
    v_pk_fma_f32 v[86:87], v[86:87], v[4:5], v[4:5] op_sel:[0,0,1] op_sel_hi:[1,0,1]
    v_cvt_pk_bf16_f32 v56, v80, v81
    v_cvt_pk_bf16_f32 v57, v82, v83
    v_cvt_pk_bf16_f32 v58, v84, v85
    v_cvt_pk_bf16_f32 v59, v86, v87
    v_mfma_f32_4x4x4_16b_bf16 v[80:83], v[100:101], v[64:65], v[96:99]
    v_mfma_f32_4x4x4_16b_bf16 v[84:87], v[100:101], v[66:67], v[96:99]
    v_pk_fma_f32 v[88:89], v[88:89], v[4:5], v[4:5] op_sel:[0,0,1] op_sel_hi:[1,0,1]
    v_pk_fma_f32 v[90:91], v[90:91], v[4:5], v[4:5] op_sel:[0,0,1] op_sel_hi:[1,0,1]
    v_pk_fma_f32 v[92:93], v[92:93], v[4:5], v[4:5] op_sel:[0,0,1] op_sel_hi:[1,0,1]
    v_pk_fma_f32 v[94:95], v[94:95], v[4:5], v[4:5] op_sel:[0,0,1] op_sel_hi:[1,0,1]
    v_cvt_pk_bf16_f32 v60, v88, v89
    v_cvt_pk_bf16_f32 v61, v90, v91
    v_cvt_pk_bf16_f32 v62, v92, v93
    v_cvt_pk_bf16_f32 v63, v94, v95
    v_mfma_f32_4x4x4_16b_bf16 v[88:91], v[100:101], v[68:69], v[96:99]
    v_mfma_f32_4x4x4_16b_bf16 v[92:95], v[100:101], v[70:71], v[96:99]
    v_pk_fma_f32 v[80:81], v[80:81], v[4:5], v[4:5] op_sel:[0,0,1] op_sel_hi:[1,0,1]
    v_pk_fma_f32 v[82:83], v[82:83], v[4:5], v[4:5] op_sel:[0,0,1] op_sel_hi:[1,0,1]
    v_pk_fma_f32 v[84:85], v[84:85], v[4:5], v[4:5] op_sel:[0,0,1] op_sel_hi:[1,0,1]
    v_pk_fma_f32 v[86:87], v[86:87], v[4:5], v[4:5] op_sel:[0,0,1] op_sel_hi:[1,0,1]
    v_cvt_pk_bf16_f32 v64, v80, v81
    v_cvt_pk_bf16_f32 v65, v82, v83
    v_cvt_pk_bf16_f32 v66, v84, v85
    v_cvt_pk_bf16_f32 v67, v86, v87
    v_mfma_f32_4x4x4_16b_bf16 v[80:83], v[100:101], v[72:73], v[96:99]
    v_mfma_f32_4x4x4_16b_bf16 v[84:87], v[100:101], v[74:75], v[96:99]
    v_pk_fma_f32 v[88:89], v[88:89], v[4:5], v[4:5] op_sel:[0,0,1] op_sel_hi:[1,0,1]
    v_pk_fma_f32 v[90:91], v[90:91], v[4:5], v[4:5] op_sel:[0,0,1] op_sel_hi:[1,0,1]
    v_pk_fma_f32 v[92:93], v[92:93], v[4:5], v[4:5] op_sel:[0,0,1] op_sel_hi:[1,0,1]
    v_pk_fma_f32 v[94:95], v[94:95], v[4:5], v[4:5] op_sel:[0,0,1] op_sel_hi:[1,0,1]
    v_cvt_pk_bf16_f32 v68, v88, v89
    v_cvt_pk_bf16_f32 v69, v90, v91
    v_cvt_pk_bf16_f32 v70, v92, v93
    v_cvt_pk_bf16_f32 v71, v94, v95
    v_mfma_f32_4x4x4_16b_bf16 v[88:91], v[100:101], v[76:77], v[96:99]
    v_mfma_f32_4x4x4_16b_bf16 v[92:95], v[100:101], v[78:79], v[96:99]
    v_pk_fma_f32 v[80:81], v[80:81], v[4:5], v[4:5] op_sel:[0,0,1] op_sel_hi:[1,0,1]
    v_pk_fma_f32 v[82:83], v[82:83], v[4:5], v[4:5] op_sel:[0,0,1] op_sel_hi:[1,0,1]
    v_pk_fma_f32 v[84:85], v[84:85], v[4:5], v[4:5] op_sel:[0,0,1] op_sel_hi:[1,0,1]
    v_pk_fma_f32 v[86:87], v[86:87], v[4:5], v[4:5] op_sel:[0,0,1] op_sel_hi:[1,0,1]
    v_cvt_pk_bf16_f32 v72, v80, v81
    v_cvt_pk_bf16_f32 v73, v82, v83
    v_cvt_pk_bf16_f32 v74, v84, v85
    v_cvt_pk_bf16_f32 v75, v86, v87
    v_pk_fma_f32 v[88:89], v[88:89], v[4:5], v[4:5] op_sel:[0,0,1] op_sel_hi:[1,0,1]
    v_pk_fma_f32 v[90:91], v[90:91], v[4:5], v[4:5] op_sel:[0,0,1] op_sel_hi:[1,0,1]
    v_pk_fma_f32 v[92:93], v[92:93], v[4:5], v[4:5] op_sel:[0,0,1] op_sel_hi:[1,0,1]
    v_pk_fma_f32 v[94:95], v[94:95], v[4:5], v[4:5] op_sel:[0,0,1] op_sel_hi:[1,0,1]
    v_cvt_pk_bf16_f32 v76, v88, v89
    v_cvt_pk_bf16_f32 v77, v90, v91
    v_cvt_pk_bf16_f32 v78, v92, v93
    v_cvt_pk_bf16_f32 v79, v94, v95
    s_cmp_eq_u32 s42, 0
    s_cbranch_scc1 L_send
L_turn2:
    s_sleep 4
    ds_read_b32 v6, v14 offset:8
    s_sub_u32 s35, s35, 1
    s_cbranch_scc1 L_end
    s_waitcnt lgkmcnt(0)
    v_readfirstlane_b32 s3, v6
    s_cmp_lt_u32 s3, 14
    s_cbranch_scc1 L_turn2
L_send:
    buffer_store_dwordx4 v[16:19], v0, s[20:23], s38 offen sc1
    buffer_store_dwordx4 v[24:27], v0, s[20:23], s38 offen offset:1024 sc1
    buffer_store_dwordx4 v[32:35], v0, s[20:23], s38 offen offset:2048 sc1
    buffer_store_dwordx4 v[40:43], v0, s[20:23], s38 offen offset:3072 sc1
    buffer_store_dwordx4 v[20:23], v0, s[20:23], s39 offen sc1
    buffer_store_dwordx4 v[28:31], v0, s[20:23], s39 offen offset:1024 sc1
    buffer_store_dwordx4 v[36:39], v0, s[20:23], s39 offen offset:2048 sc1
    buffer_store_dwordx4 v[44:47], v0, s[20:23], s39 offen offset:3072 sc1
    buffer_store_dwordx4 v[48:51], v0, s[20:23], s40 offen sc1
    buffer_store_dwordx4 v[56:59], v0, s[20:23], s40 offen offset:1024 sc1
    buffer_store_dwordx4 v[64:67], v0, s[20:23], s40 offen offset:2048 sc1
    buffer_store_dwordx4 v[72:75], v0, s[20:23], s40 offen offset:3072 sc1
    buffer_store_dwordx4 v[52:55], v0, s[20:23], s41 offen sc1
    buffer_store_dwordx4 v[60:63], v0, s[20:23], s41 offen offset:1024 sc1
    buffer_store_dwordx4 v[68:71], v0, s[20:23], s41 offen offset:2048 sc1
    buffer_store_dwordx4 v[76:79], v0, s[20:23], s41 offen offset:3072 sc1
L_end:
    s_endpgm
L_notempty:
    s_sleep 2
    ds_read_b32 v3, v14 offset:12
    s_sub_u32 s35, s35, 1
    s_cbranch_scc1 L_end
    s_waitcnt lgkmcnt(0)
    v_readfirstlane_b32 s3, v3
    s_cmp_eq_u32 s3, 0
    s_cbranch_scc1 L_notempty
    s_branch L_empty
L_getbits:
    s_movk_i32 s27, 0xff
    s_waitcnt vmcnt(0)
    s_load_dword s3, s[12:13], 192
    v_mov_b32 v3, 1
    s_waitcnt lgkmcnt(0)
    s_andn2_b32 s3, s27, s3
    s_cbranch_scc0 L_getbits2
L_getbits1:
    global_load_dword v3, v14, s[12:13] offset:192 sc1
    s_sub_u32 s35, s35, 1
    s_cbranch_scc1 L_end
    s_waitcnt vmcnt(0)
    v_readfirstlane_b32 s3, v3
    s_andn2_b32 s3, s27, s3
    s_cbranch_scc1 L_getbits1
L_getbits2:
    ds_write_b32 v14, v3 offset:12
    s_branch L_gotbits
L_yield:
    s_cmp_eq_u32 s42, 0
    s_cbranch_scc1 L_go2
    s_waitcnt lgkmcnt(0)
    s_sleep 2
    s_xor_b32 s3, s4, s10
    s_bitcmp1_b32 s3, 12
    s_cbranch_scc1 L_go2
    s_sleep 16
    s_branch L_go2
L_look:
    global_load_dword v10, v14, s[12:13] sc1
    s_sub_u32 s35, s35, 1
    s_cbranch_scc1 L_end
    s_waitcnt vmcnt(0)
    v_readfirstlane_b32 s26, v10
    s_cmp_eq_u32 s26, 0
    s_cbranch_scc1 L_look
    s_branch L_heard
.p2align 6
L_aligned:
    global_store_dword v2, v0, s[10:11] offset:2048 sc1
    global_store_dword v10, v0, s[10:11] offset:2048 sc1
    global_load_dword v12, v2, s[4:5] offset:2048 nt
    global_load_dword v13, v10, s[4:5] offset:2048 nt
    s_waitcnt vmcnt(3)
    s_nop 8
    s_getreg_b32 s3, hwreg(HW_REG_IB_STS, 0, 4)
    s_waitcnt vmcnt(1)
    s_nop 8
    s_getreg_b32 s44, hwreg(HW_REG_IB_STS, 0, 1)
    s_cmp_eq_u32 s3, 3
    s_cselect_b32 s3, 1, 0
    s_xor_b32 s44, s44, s3
    s_lshl2_add_u32 s3, s44, s3
    s_branch L_say
.section .rodata,"a"
.p2align 6
.amdhsa_kernel standalone__instancenorm__prompt_kernel
  .amdhsa_next_free_vgpr 102
  .amdhsa_next_free_sgpr 64
  .amdhsa_accum_offset 104
  .amdhsa_group_segment_fixed_size 0
  .amdhsa_kernarg_size 48
  .amdhsa_user_sgpr_count 2
  .amdhsa_user_sgpr_kernarg_segment_ptr 1
  .amdhsa_system_sgpr_workgroup_id_x 1
  .amdhsa_float_denorm_mode_32 3
.end_amdhsa_kernel
```
